```python
import torch

def _softmax(x, axis=-1):
    return torch.softmax(x, dim=axis)
def _gelu(x):
    return torch.nn.functional.gelu(x, approximate="tanh")
def _silu(x):
    return torch.nn.functional.silu(x)
def _sigmoid(x):
    return torch.sigmoid(x)
def _layernorm(x, axis=-1, eps=1e-5):
    m = x.mean(dim=axis, keepdim=True)
    v = x.var(dim=axis, keepdim=True, unbiased=False)
    return (x - m) / torch.sqrt(v + eps)
def _scatter_add(tgt, idx, src, axis=0):
    return tgt.clone().index_add_(axis, idx, src)
def _segment_sum(src, seg, n):
    out = torch.zeros((n,) + src.shape[1:], dtype=src.dtype)
    return out.index_add_(0, seg, src)
def _pad(x, pw):
    flat = tuple(v for pair in reversed(pw) for v in pair)
    return torch.nn.functional.pad(x, flat)

kernel_name = 'standalone__sequential_behavior_din__recsys'

def setup_inputs():

    _w = (lambda a: (lambda t: t.to(torch.bfloat16) if t.is_floating_point() else t)(torch.as_tensor(a)))
    B, L, D = 4096, 50, 64
    H = D
    return {
        "target": _w((lambda *s: torch.randn(*s, dtype=torch.bfloat16) * 3.2)(B, D)),
        "hist": _w((lambda *s: torch.randn(*s, dtype=torch.bfloat16) * 3.2)(B, L, D)),
        "mask": _w((lambda lo, hi, *s: torch.randint(lo, hi, s))(0, 2, B, L).to(float)),
        "w1": _w((lambda *s: torch.randn(*s, dtype=torch.bfloat16) * 3.2)(4 * D, H) * (4 * D) ** -0.5),
        "b1": _w((lambda *s: torch.randn(*s, dtype=torch.bfloat16) * 3.2)(H) * 0.1),
        "w2": _w((lambda *s: torch.randn(*s, dtype=torch.bfloat16) * 0.05)(H, 1) * H ** -0.5),
        "b2": _w((lambda *s: torch.randn(*s, dtype=torch.bfloat16) * 0.05)(1) * 0.1),
    }

def reference(target, hist, mask, w1, b1, w2, b2):
    L = hist.shape[1]
    tgt = (lambda x, n, axis: torch.repeat_interleave(x, n, dim=axis))(target[:, None, :], L, axis=1)
    feat = torch.concatenate([hist, tgt, hist - tgt, hist * tgt], axis=-1)
    h = _sigmoid(feat @ w1 + b1)
    scores = (h @ w2 + b2)[..., 0] * mask
    return torch.einsum('bl,bld->bd', scores, hist)
```

```asm
; @launch grid=(256,1,1) block=(1024,1,1) lds=161296
.amdgcn_target "amdgcn-amd-amdhsa--gfx950"
.text
.globl standalone__sequential_behavior_din__recsys_kernel
.p2align 8
.type standalone__sequential_behavior_din__recsys_kernel,@function
standalone__sequential_behavior_din__recsys_kernel:
    s_cmp_ge_u32 s2, 256
    s_cbranch_scc1 L_end
    s_load_dwordx16 s[4:19], s[0:1], 0
    s_setprio 3
    s_getpc_b64 s[36:37]
    v_lshlrev_b32 v126, 7, v0
    v_cmp_gt_u32 vcc, 44, v0
    s_and_saveexec_b64 s[38:39], vcc
    s_cbranch_execz L_ncpf
    global_load_dword v127, v126, s[36:37]
L_ncpf:
    s_mov_b64 exec, s[38:39]
    v_lshrrev_b32 v4, 6, v0
    v_and_b32 v1, 63, v0
    v_readfirstlane_b32 s20, v4
    v_lshlrev_b32 v2, 4, v1
    s_lshl_b32 s21, s2, 4
    v_lshlrev_b32 v5, 1, v1
    s_add_u32 s21, s21, s20
    v_mov_b32 v3, 0
    s_mul_i32 s22, s21, 100
    v_lshlrev_b32 v6, 2, v1
    v_add_u32 v60, s22, v5
    s_lshl_b32 s45, s21, 7
    v_and_b32 v7, 0x40, v6
    v_add_u32 v16, s45, v5
    s_mul_i32 s43, s20, 592
    v_xor_b32 v7, v2, v7
    s_add_u32 s43, s43, 147456
    v_and_b32 v8, 0x70, v7
    s_and_b32 s24, s20, 3
    v_xor_b32 v9, 32, v8
    s_lshr_b32 s25, s20, 2
    v_add_u32 v4, s43, v6
    v_mov_b32 v17, 159232
    ds_write_b32 v4, v3 offset:64
    v_add_u32 v4, s43, v1
    v_mov_b32 v5, -1
    ds_write_b8 v4, v5
    v_lshrrev_b32 v7, 3, v1
    s_mul_i32 s23, s21, 6400
    v_add_u32 v10, s43, v7
    s_lshl_b32 s42, s20, 13
    s_movk_i32 s30, 6400
    s_mov_b32 s31, 0x20000
    ds_write_b32 v17, v3
    ds_write_b32 v17, v3 offset:4
    s_mov_b32 exec_hi, 0x3ffff
    s_waitcnt lgkmcnt(0)
    global_load_ushort v3, v60, s[8:9] nt
    s_mov_b64 exec, -1
    s_add_u32 s28, s6, s23
    s_addc_u32 s29, s7, 0
    s_cmp_lt_u32 s25, 2
    s_cbranch_scc0 L_B
    v_and_b32 v4, 0x180, v2
    v_lshlrev_b32 v5, 5, v1
    v_and_b32 v5, 0x400, v5
    s_mul_i32 s36, s24, 0xa00
    s_and_b32 s36, s36, 0x1200
    v_or3_b32 v4, v4, v5, v8
    v_add_u32 v61, s36, v4
    v_xor_b32 v62, 32, v61
    v_add_u32 v62, 1024, v62
    s_cmp_eq_u32 s25, 0
    s_cbranch_scc0 L_r1
    s_lshl_b32 s26, s24, 14
    s_add_u32 s26, s26, 6144
    s_mov_b32 m0, s26
    s_getpc_b64 s[34:35]
L_pc:
    s_add_u32 s34, s34, L_tab-L_pc
    s_addc_u32 s35, s35, 0
    s_and_b32 s36, s20, 1
    s_lshl_b32 s36, s36, 10
    v_add_u32 v4, s36, v2
    s_barrier
    global_load_lds_dwordx4 v61, s[10:11]
    global_load_lds_dwordx4 v62, s[10:11] offset:1024
    s_add_u32 s32, s10, 16384
    s_addc_u32 s33, s11, 0
    s_add_u32 m0, m0, 8192
    s_mov_b32 s46, 0xbfb8aa3b
    global_load_lds_dwordx4 v61, s[32:33]
    global_load_lds_dwordx4 v62, s[32:33] offset:1024
    s_add_u32 m0, s36, 159248
    s_movk_i32 s38, 0x2010
    s_mov_b32 s39, 8
    global_load_lds_dwordx4 v4, s[34:35]
    s_branch L_A2
L_r1:
    s_lshl_b32 s26, s24, 13
    s_add_u32 s26, s26, 71680
    s_mov_b32 m0, s26
    s_lshl_b32 s36, s2, 11
    s_lshl_b32 s37, s24, 10
    s_add_u32 s36, s36, s37
    s_add_u32 s37, s37, 156928
    s_add_u32 s32, s10, 24576
    s_addc_u32 s33, s11, 0
    s_barrier
    global_load_lds_dwordx4 v61, s[32:33]
    global_load_lds_dwordx4 v62, s[32:33] offset:1024
    s_add_u32 s32, s4, s36
    s_addc_u32 s33, s5, 0
    s_cmp_eq_u32 s24, 2
    s_cselect_b64 s[32:33], s[14:15], s[32:33]
    s_cselect_b32 s37, 158976, s37
    s_cmp_eq_u32 s24, 3
    s_cselect_b64 s[32:33], s[12:13], s[32:33]
    s_cselect_b32 s37, 159104, s37
    s_mov_b32 m0, s37
    s_cmp_lt_u32 s24, 2
    s_cselect_b64 exec, -1, 0xff
    global_load_lds_dwordx4 v2, s[32:33]
    s_mov_b32 s46, 0xbf38aa3b
    s_movk_i32 s38, 0x10
    s_mov_b32 s39, 0
L_A2:
    s_mov_b64 exec, -1
    s_mov_b32 m0, s42
    v_mov_b32 v4, 0x3f80
    v_lshrrev_b32 v5, 1, v1
    v_and_b32 v5, 8, v5
    v_and_b32 v6, 15, v1
    v_xor_b32 v5, v5, v6
    v_lshrrev_b32 v5, 1, v5
    v_cmp_eq_u32_e64 s[48:49], 0, v5
    v_cmp_eq_u32_e64 s[50:51], 1, v5
    v_cmp_eq_u32_e64 s[52:53], 2, v5
    v_cmp_eq_u32_e64 s[54:55], 3, v5
    v_and_b32 v7, 16, v2
    v_lshlrev_b32 v5, v7, v4
    v_lshlrev_b32 v6, 7, v6
    v_lshlrev_b32 v4, 2, v1
    v_cndmask_b32_e64 v20, 0, v5, s[48:49]
    v_cndmask_b32_e64 v21, 0, v5, s[50:51]
    v_cndmask_b32_e64 v22, 0, v5, s[52:53]
    v_cndmask_b32_e64 v23, 0, v5, s[54:55]
    v_and_b32 v4, 0x20, v4
    v_lshlrev_b32 v7, 5, v1
    v_and_b32 v7, 0x40, v7
    v_or3_b32 v6, v6, v4, v7
    v_and_b32 v4, 0x30, v1
    v_mul_u32_u24 v5, 0x101, v4
    v_and_b32 v5, s38, v5
    v_add3_u32 v44, v6, v5, s26
    v_xor_b32 v45, 32, v44
    v_xor_b32 v46, 64, v44
    v_xor_b32 v47, 96, v44
    s_lshl_b32 s45, s24, 12
    s_add_u32 s45, s45, s39
    s_add_u32 s45, s45, 131072
    v_add_u32 v48, s45, v2
    s_mov_b32 s47, s46
    s_waitcnt vmcnt(1)
    ds_read_b128 v[64:67], v44
    ds_read_b128 v[68:71], v45
    ds_read_b128 v[72:75], v46
    ds_read_b128 v[76:79], v47
    s_waitcnt lgkmcnt(3)
    v_mfma_f32_16x16x32_bf16 v[80:83], v[64:67], v[20:23], 0
    s_waitcnt lgkmcnt(2)
    v_mfma_f32_16x16x32_bf16 v[84:87], v[68:71], v[20:23], 0
    s_waitcnt lgkmcnt(1)
    v_mfma_f32_16x16x32_bf16 v[88:91], v[72:75], v[20:23], 0
    s_waitcnt lgkmcnt(0)
    v_mfma_f32_16x16x32_bf16 v[92:95], v[76:79], v[20:23], 0
    s_nop 1
    v_pk_mul_f32 v[80:81], v[80:81], s[46:47]
    v_pk_mul_f32 v[82:83], v[82:83], s[46:47]
    s_nop 0
    v_pk_mul_f32 v[84:85], v[84:85], s[46:47]
    v_pk_mul_f32 v[86:87], v[86:87], s[46:47]
    v_pk_mul_f32 v[88:89], v[88:89], s[46:47]
    v_pk_mul_f32 v[90:91], v[90:91], s[46:47]
    v_pk_mul_f32 v[92:93], v[92:93], s[46:47]
    v_pk_mul_f32 v[94:95], v[94:95], s[46:47]
    v_cvt_pk_bf16_f32 v96, v80, v81
    v_cvt_pk_bf16_f32 v97, v82, v83
    ds_write_b64 v48, v[96:97] offset:0
    v_cvt_pk_bf16_f32 v98, v84, v85
    v_cvt_pk_bf16_f32 v99, v86, v87
    ds_write_b64 v48, v[98:99] offset:1024
    v_cvt_pk_bf16_f32 v100, v88, v89
    v_cvt_pk_bf16_f32 v101, v90, v91
    ds_write_b64 v48, v[100:101] offset:2048
    v_cvt_pk_bf16_f32 v102, v92, v93
    v_cvt_pk_bf16_f32 v103, v94, v95
    ds_write_b64 v48, v[102:103] offset:3072
    s_waitcnt vmcnt(0)
    v_mov_b32 v5, 1
    s_mov_b64 exec, 1
    ds_add_u32 v17, v5 offset:0
    s_mov_b64 exec, -1
    s_branch L_compact
L_B:
    v_and_b32 v4, 12, v1
    v_lshlrev_b32 v4, 8, v4
    v_and_b32 v5, 3, v1
    v_lshlrev_b32 v5, 7, v5
    v_and_b32 v6, 16, v1
    v_or3_b32 v4, v4, v5, v6
    s_lshl_b32 s36, s24, 5
    s_add_u32 s36, s36, 8192
    v_add_u32 v4, s36, v4
    v_add_u32 v5, 4096, v4
    s_mov_b32 m0, s42
    s_barrier
    s_setprio 3
    v_mov_b32 v44, v4
    v_mov_b32 v45, v5
    s_waitcnt vmcnt(0)
L_compact:
    v_and_b32 v4, 0x7fff, v3
    v_cmp_ne_u32 vcc, 0, v4
    v_lshlrev_b32 v3, 16, v3
    s_bcnt1_i32_b64 s41, vcc
    v_mbcnt_lo_u32_b32 v4, vcc_lo, 0
    v_mbcnt_hi_u32_b32 v4, vcc_hi, v4
    v_add_u32 v5, s43, v4
    s_mov_b64 exec, vcc
    ds_write_b8 v5, v1
    s_mov_b64 exec, -1
    ds_read_u8 v36, v10 offset:0
    ds_read_u8 v37, v10 offset:8
    ds_read_u8 v38, v10 offset:16
    ds_read_u8 v39, v10 offset:24
    ds_read_u8 v40, v10 offset:32
    ds_read_u8 v41, v10 offset:40
    s_add_u32 s40, s41, 15
    s_lshr_b32 s40, s40, 4
    s_min_u32 s44, s40, 3
    v_lshl_add_u32 v35, v4, 2, s43
    s_cmp_eq_u32 s25, 2
    s_cbranch_scc0 L_nowb
    s_mov_b32 exec_hi, 0
    global_load_dwordx4 v[64:67], v44, s[10:11]
    global_load_dwordx4 v[68:71], v44, s[10:11] offset:512
    global_load_dwordx4 v[72:75], v45, s[10:11]
    global_load_dwordx4 v[76:79], v45, s[10:11] offset:512
    s_mov_b64 exec, -1
    s_branch L_biasjob
L_nowb:
    s_cmp_le_u32 s40, 0
    s_cbranch_scc1 L_dma_doneB
    s_waitcnt lgkmcnt(4)
    v_lshl_add_u32 v42, v36, 7, v8
    buffer_load_dwordx4 v42, s[28:31], 0 offen nt lds
    s_add_u32 m0, m0, 1024
    v_lshl_add_u32 v43, v37, 7, v9
    buffer_load_dwordx4 v43, s[28:31], 0 offen nt lds
    s_add_u32 m0, m0, 1024
    s_cmp_le_u32 s40, 1
    s_cbranch_scc1 L_dma_doneB
    s_waitcnt lgkmcnt(2)
    v_lshl_add_u32 v42, v38, 7, v8
    buffer_load_dwordx4 v42, s[28:31], 0 offen nt lds
    s_add_u32 m0, m0, 1024
    v_lshl_add_u32 v43, v39, 7, v9
    buffer_load_dwordx4 v43, s[28:31], 0 offen nt lds
    s_add_u32 m0, m0, 1024
    s_cmp_le_u32 s40, 2
    s_cbranch_scc1 L_dma_doneB
    s_waitcnt lgkmcnt(0)
    v_lshl_add_u32 v42, v40, 7, v8
    buffer_load_dwordx4 v42, s[28:31], 0 offen nt lds
    s_add_u32 m0, m0, 1024
    v_lshl_add_u32 v43, v41, 7, v9
    buffer_load_dwordx4 v43, s[28:31], 0 offen nt lds
    s_add_u32 m0, m0, 1024
L_dma_doneB:
    s_mov_b64 exec, vcc
    ds_write_b32 v35, v3 offset:64
    s_mov_b64 exec, -1
L_jobdone:
    s_waitcnt lgkmcnt(0)
    s_load_dword s27, s[16:17], 0
    s_setprio 1
    v_add_u32 v32, 131072, v2
    v_and_b32 v4, 0x30, v1
    v_add_u32 v15, s43, v4
    s_lshl_b32 s45, s20, 7
    s_add_u32 s45, s45, 156928
    v_add_u32 v33, s45, v4
    v_lshrrev_b32 v5, 1, v4
    v_add_u32 v30, 158976, v5
    s_movk_i32 s57, 0x4000
L_sp1:
    ds_read_b32 v5, v17 offset:0
    s_waitcnt lgkmcnt(0)
    v_readfirstlane_b32 s45, v5
    s_cmp_ge_u32 s45, 8
    s_cbranch_scc1 L_sd1
    s_sleep 1
    s_sub_u32 s57, s57, 1
    s_cmp_lg_u32 s57, 0
    s_cbranch_scc1 L_sp1
L_sd1:
    s_setprio 3
    ds_read_b128 v[26:29], v32 offset:28176
    ds_read_b64 v[124:125], v32 offset:29200
    ds_read_b128 v[68:71], v33
    ds_read_b128 v[72:75], v33 offset:64
    ds_read_b128 v[76:79], v32 offset:0
    ds_read_b128 v[80:83], v32 offset:1024
    ds_read_b128 v[84:87], v32 offset:2048
    ds_read_b128 v[88:91], v32 offset:3072
    ds_read_b128 v[92:95], v32 offset:4096
    ds_read_b128 v[96:99], v32 offset:5120
    ds_read_b128 v[100:103], v32 offset:6144
    ds_read_b128 v[104:107], v32 offset:7168
    s_lshl_b32 s27, s27, 16
    s_waitcnt lgkmcnt(8)
    v_and_b32 v24, v68, v28
    v_and_b32 v25, v69, v29
    v_add_u32 v11, s42, v124
    v_add_u32 v13, s42, v125
    v_xor_b32 v12, 64, v11
    v_xor_b32 v14, 32, v13
    s_waitcnt lgkmcnt(4)
    v_mfma_f32_16x16x32_bf16 v[108:111], v[24:27], v[76:79], 0
    v_mfma_f32_16x16x32_bf16 v[112:115], v[24:27], v[80:83], 0
    v_mfma_f32_16x16x32_bf16 v[116:119], v[24:27], v[84:87], 0
    v_mfma_f32_16x16x32_bf16 v[120:123], v[24:27], v[88:91], 0
    ds_read_b128 v[76:79], v32 offset:8192
    ds_read_b128 v[80:83], v32 offset:9216
    ds_read_b128 v[84:87], v32 offset:10240
    ds_read_b128 v[88:91], v32 offset:11264
    v_and_b32 v24, v70, v28
    v_and_b32 v25, v71, v29
    v_cvt_pk_bf16_f32 v36, v108, v109
    v_cvt_pk_bf16_f32 v37, v110, v111
    v_cvt_pk_bf16_f32 v44, v112, v113
    v_cvt_pk_bf16_f32 v45, v114, v115
    v_cvt_pk_bf16_f32 v52, v116, v117
    v_cvt_pk_bf16_f32 v53, v118, v119
    v_cvt_pk_bf16_f32 v60, v120, v121
    v_cvt_pk_bf16_f32 v61, v122, v123
    s_waitcnt lgkmcnt(4)
    v_mfma_f32_16x16x32_bf16 v[108:111], v[24:27], v[92:95], 0
    v_mfma_f32_16x16x32_bf16 v[112:115], v[24:27], v[96:99], 0
    v_mfma_f32_16x16x32_bf16 v[116:119], v[24:27], v[100:103], 0
    v_mfma_f32_16x16x32_bf16 v[120:123], v[24:27], v[104:107], 0
    ds_read_b128 v[92:95], v32 offset:12288
    ds_read_b128 v[96:99], v32 offset:13312
    ds_read_b128 v[100:103], v32 offset:14336
    ds_read_b128 v[104:107], v32 offset:15360
    v_and_b32 v24, v72, v28
    v_and_b32 v25, v73, v29
    v_cvt_pk_bf16_f32 v38, v108, v109
    v_cvt_pk_bf16_f32 v39, v110, v111
    v_cvt_pk_bf16_f32 v46, v112, v113
    v_cvt_pk_bf16_f32 v47, v114, v115
    v_cvt_pk_bf16_f32 v54, v116, v117
    v_cvt_pk_bf16_f32 v55, v118, v119
    v_cvt_pk_bf16_f32 v62, v120, v121
    v_cvt_pk_bf16_f32 v63, v122, v123
    s_waitcnt lgkmcnt(4)
    v_mfma_f32_16x16x32_bf16 v[108:111], v[24:27], v[76:79], 0
    v_mfma_f32_16x16x32_bf16 v[112:115], v[24:27], v[80:83], 0
    v_mfma_f32_16x16x32_bf16 v[116:119], v[24:27], v[84:87], 0
    v_mfma_f32_16x16x32_bf16 v[120:123], v[24:27], v[88:91], 0
    v_and_b32 v24, v74, v28
    v_and_b32 v25, v75, v29
    s_nop 3
    v_cvt_pk_bf16_f32 v40, v108, v109
    v_cvt_pk_bf16_f32 v41, v110, v111
    v_cvt_pk_bf16_f32 v48, v112, v113
    v_cvt_pk_bf16_f32 v49, v114, v115
    v_cvt_pk_bf16_f32 v56, v116, v117
    v_cvt_pk_bf16_f32 v57, v118, v119
    v_cvt_pk_bf16_f32 v64, v120, v121
    v_cvt_pk_bf16_f32 v65, v122, v123
    s_waitcnt lgkmcnt(0)
    v_mfma_f32_16x16x32_bf16 v[108:111], v[24:27], v[92:95], 0
    v_mfma_f32_16x16x32_bf16 v[112:115], v[24:27], v[96:99], 0
    v_mfma_f32_16x16x32_bf16 v[116:119], v[24:27], v[100:103], 0
    v_mfma_f32_16x16x32_bf16 v[120:123], v[24:27], v[104:107], 0
    ds_read_b128 v[80:83], v17 offset:272
    ds_read2_b64 v[68:71], v30 offset0:0 offset1:4
    ds_read2_b64 v[72:75], v30 offset0:8 offset1:12
    v_mov_b32 v76, s27
    v_mov_b32 v77, v76
    v_mov_b32 v78, v76
    v_mov_b32 v79, v76
    v_cvt_pk_bf16_f32 v42, v108, v109
    v_cvt_pk_bf16_f32 v43, v110, v111
    v_cvt_pk_bf16_f32 v50, v112, v113
    v_cvt_pk_bf16_f32 v51, v114, v115
    v_cvt_pk_bf16_f32 v58, v116, v117
    v_cvt_pk_bf16_f32 v59, v118, v119
    v_cvt_pk_bf16_f32 v66, v120, v121
    v_cvt_pk_bf16_f32 v67, v122, v123
    s_movk_i32 s57, 0x4000
L_sp2:
    ds_read_b32 v5, v17 offset:4
    s_waitcnt lgkmcnt(0)
    v_readfirstlane_b32 s45, v5
    s_cmp_ge_u32 s45, 4
    s_cbranch_scc1 L_sd2
    s_sleep 1
    s_sub_u32 s57, s57, 1
    s_cmp_lg_u32 s57, 0
    s_cbranch_scc1 L_sp2
L_sd2:
    ds_read_b128 v[20:23], v15 offset:320
    ds_read_b128 v[24:27], v15 offset:384
    ds_read_b128 v[28:31], v15 offset:448
    ds_read_b128 v[32:35], v15 offset:512
    s_setprio 3
    s_cmp_lt_u32 s40, 4
    s_cbranch_scc1 L_not4
    ds_read_u8 v4, v10 offset:48
    ds_read_u8 v5, v10 offset:56
    s_waitcnt lgkmcnt(0)
    v_lshl_add_u32 v4, v4, 7, v8
    buffer_load_dwordx4 v4, s[28:31], 0 offen nt lds
    s_add_u32 m0, m0, 1024
    v_lshl_add_u32 v5, v5, 7, v9
    buffer_load_dwordx4 v5, s[28:31], 0 offen nt lds
L_not4:
    s_cmp_eq_u32 s40, 0
    s_cbranch_scc1 L_out
    s_sub_u32 s45, s40, 1
    s_sub_u32 s56, s41, 1
    s_and_b32 s56, s56, 8
    s_cselect_b32 s56, -1, 0
    s_cmp_eq_u32 s45, s56
    s_cbranch_scc1 L_half
L_tile:
    ds_read_b128 v[84:87], v15 offset:64
    s_cmp_eq_u32 s45, 1
    s_cbranch_scc1 L_w3_1
    s_cmp_eq_u32 s45, 0
    s_cbranch_scc1 L_w3_0
    s_cmp_eq_u32 s45, 2
    s_cbranch_scc1 L_w3_2
    s_waitcnt vmcnt(6)
    s_branch L_w3_d
L_w3_2:
    s_waitcnt vmcnt(4)
    s_branch L_w3_d
L_w3_0:
    s_waitcnt vmcnt(0)
    s_branch L_w3_d
L_w3_1:
    s_waitcnt vmcnt(2)
L_w3_d:
    ds_read_b128 v[108:111], v11
    ds_read_b128 v[112:115], v12
    ds_read_b64_tr_b16 v[116:117], v13
    ds_read_b64_tr_b16 v[118:119], v13 offset:512
    ds_read_b64_tr_b16 v[120:121], v14 offset:1024
    ds_read_b64_tr_b16 v[122:123], v14 offset:1536
    s_waitcnt lgkmcnt(5)
    v_mfma_f32_16x16x32_bf16 v[92:95], v[36:39], v[108:111], v[20:23]
    v_mfma_f32_16x16x32_bf16 v[96:99], v[44:47], v[108:111], v[24:27]
    s_waitcnt lgkmcnt(4)
    v_mfma_f32_16x16x32_bf16 v[92:95], v[40:43], v[112:115], v[92:95]
    v_mfma_f32_16x16x32_bf16 v[96:99], v[48:51], v[112:115], v[96:99]
    v_add_u32 v11, 2048, v11
    v_add_u32 v12, 2048, v12
    v_add_u32 v13, 2048, v13
    v_add_u32 v14, 2048, v14
    v_add_u32 v15, 64, v15
    v_mfma_f32_16x16x32_bf16 v[100:103], v[52:55], v[108:111], v[28:31]
    v_mfma_f32_16x16x32_bf16 v[104:107], v[60:63], v[108:111], v[32:35]
    v_exp_f32 v92, v92
    v_exp_f32 v93, v93
    v_mfma_f32_16x16x32_bf16 v[100:103], v[56:59], v[112:115], v[100:103]
    v_exp_f32 v94, v94
    v_exp_f32 v95, v95
    v_mfma_f32_16x16x32_bf16 v[104:107], v[64:67], v[112:115], v[104:107]
    v_exp_f32 v96, v96
    v_exp_f32 v97, v97
    v_exp_f32 v98, v98
    v_exp_f32 v99, v99
    v_pk_add_f32 v[92:93], v[92:93], 1.0 op_sel_hi:[1,0]
    v_pk_add_f32 v[94:95], v[94:95], 1.0 op_sel_hi:[1,0]
    v_pk_add_f32 v[96:97], v[96:97], 1.0 op_sel_hi:[1,0]
    v_pk_add_f32 v[98:99], v[98:99], 1.0 op_sel_hi:[1,0]
    v_exp_f32 v100, v100
    v_exp_f32 v101, v101
    v_exp_f32 v102, v102
    v_exp_f32 v103, v103
    v_exp_f32 v104, v104
    v_exp_f32 v105, v105
    v_exp_f32 v106, v106
    v_exp_f32 v107, v107
    s_cmp_eq_u32 s45, 0
    s_setprio 2
    s_cbranch_scc0 L_mid
    s_setprio 1
L_mid:
    v_rcp_f32 v92, v92
    v_rcp_f32 v93, v93
    v_rcp_f32 v94, v94
    v_rcp_f32 v95, v95
    v_rcp_f32 v96, v96
    v_rcp_f32 v97, v97
    v_rcp_f32 v98, v98
    v_rcp_f32 v99, v99
    v_pk_add_f32 v[100:101], v[100:101], 1.0 op_sel_hi:[1,0]
    v_pk_add_f32 v[102:103], v[102:103], 1.0 op_sel_hi:[1,0]
    v_pk_add_f32 v[104:105], v[104:105], 1.0 op_sel_hi:[1,0]
    v_pk_add_f32 v[106:107], v[106:107], 1.0 op_sel_hi:[1,0]
    v_cvt_pk_bf16_f32 v92, v92, v93
    v_cvt_pk_bf16_f32 v93, v94, v95
    v_cvt_pk_bf16_f32 v94, v96, v97
    v_cvt_pk_bf16_f32 v95, v98, v99
    v_rcp_f32 v100, v100
    v_rcp_f32 v101, v101
    v_mfma_f32_16x16x32_bf16 v[88:91], v[92:95], v[68:71], v[76:79]
    v_rcp_f32 v102, v102
    v_rcp_f32 v103, v103
    v_rcp_f32 v104, v104
    v_rcp_f32 v105, v105
    v_rcp_f32 v106, v106
    v_rcp_f32 v107, v107
    v_cvt_pk_bf16_f32 v100, v100, v101
    v_cvt_pk_bf16_f32 v101, v102, v103
    v_cvt_pk_bf16_f32 v102, v104, v105
    v_cvt_pk_bf16_f32 v103, v106, v107
    s_nop 1
    v_mfma_f32_16x16x32_bf16 v[88:91], v[100:103], v[72:75], v[88:91]
    s_setprio 0
    s_cbranch_scc1 L_mid2
    s_setprio 2
L_mid2:
    s_nop 6
    v_pk_mul_f32 v[88:89], v[88:89], v[84:85]
    v_pk_mul_f32 v[90:91], v[90:91], v[86:87]
    v_cvt_pk_bf16_f32 v124, v88, v89
    v_cvt_pk_bf16_f32 v125, v90, v91
    s_waitcnt lgkmcnt(0)
    s_nop 0
    v_mfma_f32_4x4x4_16b_bf16 v[80:83], v[124:125], v[116:117], v[80:83] cbsz:4 abid:0
    s_nop 1
    v_mfma_f32_4x4x4_16b_bf16 v[80:83], v[124:125], v[118:119], v[80:83] cbsz:4 abid:4
    s_nop 1
    v_mfma_f32_4x4x4_16b_bf16 v[80:83], v[124:125], v[120:121], v[80:83] cbsz:4 abid:8
    s_nop 1
    v_mfma_f32_4x4x4_16b_bf16 v[80:83], v[124:125], v[122:123], v[80:83] cbsz:4 abid:12
    s_cmp_eq_u32 s45, 0
    s_cbranch_scc1 L_out
    s_sub_u32 s45, s45, 1
    s_cmp_eq_u32 s45, s56
    s_cbranch_scc0 L_tile
L_half:
    v_lshlrev_b32 v4, 3, v1
    v_and_b32 v5, 0x40, v4
    v_and_b32 v6, 0x30, v1
    v_add3_u32 v5, v5, v6, s43
    ds_read_b128 v[92:95], v5 offset:320
    ds_read_b128 v[96:99], v5 offset:448
    v_and_b32 v4, 0x20, v4
    v_lshrrev_b32 v6, 1, v6
    s_mov_b32 s36, 158976
    v_add3_u32 v4, v4, v6, s36
    ds_read2_b64 v[68:71], v4 offset0:0 offset1:8
    v_and_b32 v6, 0x20, v1
    v_sub_u32 v15, v15, v6
    ds_read_b128 v[84:87], v15 offset:64
    v_xor_b32 v4, 0x420, v11
    v_xor_b32 v5, 0x420, v12
    v_mul_f32 v76, 0.5, v76
    s_waitcnt vmcnt(0)
    ds_read_b128 v[108:111], v11
    ds_read_b128 v[100:103], v4
    ds_read_b128 v[112:115], v12
    ds_read_b128 v[104:107], v5
    ds_read_b64_tr_b16 v[116:117], v13
    ds_read_b64_tr_b16 v[118:119], v13 offset:512
    v_mov_b32 v77, v76
    v_mov_b32 v78, v76
    v_mov_b32 v79, v76
    s_waitcnt lgkmcnt(5)
    v_mfma_f32_16x16x32_bf16 v[92:95], v[36:39], v[108:111], v[92:95]
    v_mfma_f32_16x16x32_bf16 v[96:99], v[52:55], v[108:111], v[96:99]
    s_waitcnt lgkmcnt(4)
    v_mfma_f32_16x16x32_bf16 v[92:95], v[44:47], v[100:103], v[92:95]
    v_mfma_f32_16x16x32_bf16 v[96:99], v[60:63], v[100:103], v[96:99]
    s_waitcnt lgkmcnt(3)
    v_mfma_f32_16x16x32_bf16 v[92:95], v[40:43], v[112:115], v[92:95]
    v_mfma_f32_16x16x32_bf16 v[96:99], v[56:59], v[112:115], v[96:99]
    s_waitcnt lgkmcnt(2)
    v_mfma_f32_16x16x32_bf16 v[92:95], v[48:51], v[104:107], v[92:95]
    v_mfma_f32_16x16x32_bf16 v[96:99], v[64:67], v[104:107], v[96:99]
    s_nop 6
    v_exp_f32 v92, v92
    v_exp_f32 v93, v93
    v_exp_f32 v94, v94
    v_exp_f32 v95, v95
    v_exp_f32 v96, v96
    v_exp_f32 v97, v97
    v_exp_f32 v98, v98
    v_exp_f32 v99, v99
    v_pk_add_f32 v[92:93], v[92:93], 1.0 op_sel_hi:[1,0]
    v_pk_add_f32 v[94:95], v[94:95], 1.0 op_sel_hi:[1,0]
    v_pk_add_f32 v[96:97], v[96:97], 1.0 op_sel_hi:[1,0]
    v_pk_add_f32 v[98:99], v[98:99], 1.0 op_sel_hi:[1,0]
    s_setprio 1
    v_rcp_f32 v92, v92
    v_rcp_f32 v93, v93
    v_rcp_f32 v94, v94
    v_rcp_f32 v95, v95
    v_rcp_f32 v96, v96
    v_rcp_f32 v97, v97
    v_rcp_f32 v98, v98
    v_rcp_f32 v99, v99
    v_cvt_pk_bf16_f32 v92, v92, v93
    v_cvt_pk_bf16_f32 v93, v94, v95
    v_cvt_pk_bf16_f32 v94, v96, v97
    v_cvt_pk_bf16_f32 v95, v98, v99
    s_nop 1
    v_mfma_f32_16x16x32_bf16 v[88:91], v[92:95], v[68:71], v[76:79]
    s_setprio 0
    s_nop 6
    v_pk_mul_f32 v[88:89], v[88:89], v[84:85]
    v_pk_mul_f32 v[90:91], v[90:91], v[86:87]
    v_cvt_pk_bf16_f32 v124, v88, v89
    v_cvt_pk_bf16_f32 v125, v90, v91
    s_waitcnt lgkmcnt(0)
    s_nop 0
    v_mfma_f32_4x4x4_16b_bf16 v[80:83], v[124:125], v[116:117], v[80:83] cbsz:4 abid:0
    s_nop 1
    v_mfma_f32_4x4x4_16b_bf16 v[80:83], v[124:125], v[118:119], v[80:83] cbsz:4 abid:4
    s_nop 1
    v_mfma_f32_4x4x4_16b_bf16 v[80:83], v[124:125], v[116:117], v[80:83] cbsz:4 abid:9
    s_nop 1
    v_mfma_f32_4x4x4_16b_bf16 v[80:83], v[124:125], v[118:119], v[80:83] cbsz:4 abid:13
L_out:
    s_nop 4
    v_cvt_pk_bf16_f32 v4, v80, v80
    global_store_short v16, v4, s[18:19]
L_end:
    s_endpgm
L_biasjob:
    v_lshlrev_b32 v4, 10, v1
    v_and_b32 v4, 0x8000, v4
    v_or_b32 v4, 0x3f80, v4
    v_lshrrev_b32 v5, 1, v1
    v_and_b32 v5, 8, v5
    v_and_b32 v6, 15, v1
    v_xor_b32 v5, v5, v6
    v_lshrrev_b32 v5, 1, v5
    v_cmp_eq_u32_e64 s[48:49], 0, v5
    v_cmp_eq_u32_e64 s[50:51], 1, v5
    v_cmp_eq_u32_e64 s[52:53], 2, v5
    v_cmp_eq_u32_e64 s[54:55], 3, v5
    v_and_b32 v7, 16, v2
    v_lshlrev_b32 v5, v7, v4
    v_lshlrev_b32 v6, 7, v6
    v_lshlrev_b32 v4, 2, v1
    v_cndmask_b32_e64 v20, 0, v5, s[48:49]
    v_cndmask_b32_e64 v21, 0, v5, s[50:51]
    v_cndmask_b32_e64 v22, 0, v5, s[52:53]
    v_cndmask_b32_e64 v23, 0, v5, s[54:55]
    v_and_b32 v4, 0x20, v4
    v_lshlrev_b32 v7, 5, v1
    v_and_b32 v7, 0x40, v7
    v_or3_b32 v6, v6, v4, v7
    v_and_b32 v5, 16, v1
    s_lshl_b32 s45, s24, 5
    v_or_b32 v6, v6, v5
    v_xor_b32 v44, s45, v6
    v_and_b32 v4, 15, v1
    v_and_b32 v5, 0x30, v1
    v_lshl_add_u32 v6, v4, 7, v5
    v_add_u32 v45, 156928, v6
    v_mul_u32_u24 v4, 592, v4
    v_lshrrev_b32 v6, 1, v5
    s_add_u32 s45, s45, 159104
    v_add_u32 v46, s45, v6
    s_lshl_b32 s45, s24, 6
    s_add_u32 s45, s45, 147776
    v_add3_u32 v47, v4, v5, s45
    s_mov_b32 s46, 0xbfb8aa3b
    s_mov_b32 s47, s46
    s_movk_i32 s57, 0x4000
L_sp4:
    ds_read_b32 v5, v17 offset:0
    s_waitcnt lgkmcnt(0)
    v_readfirstlane_b32 s45, v5
    s_cmp_ge_u32 s45, 8
    s_cbranch_scc1 L_sd4
    s_sleep 1
    s_sub_u32 s57, s57, 1
    s_cmp_lg_u32 s57, 0
    s_cbranch_scc1 L_sp4
L_sd4:
    s_mov_b32 exec_lo, 0
    ds_read_b128 v[64:67], v44 offset:14336
    ds_read_b128 v[68:71], v44 offset:30720
    ds_read_b128 v[72:75], v44 offset:47104
    ds_read_b128 v[76:79], v44 offset:63488
    s_mov_b64 exec, -1
    ds_read_b128 v[104:107], v45
    ds_read_b128 v[108:111], v45 offset:64
    ds_read_b64 v[112:113], v46
    s_waitcnt vmcnt(0)
    s_waitcnt lgkmcnt(6)
    v_mfma_f32_16x16x32_bf16 v[80:83], v[64:67], v[20:23], 0
    s_waitcnt lgkmcnt(5)
    v_mfma_f32_16x16x32_bf16 v[84:87], v[68:71], v[20:23], 0
    s_waitcnt lgkmcnt(4)
    v_mfma_f32_16x16x32_bf16 v[88:91], v[72:75], v[20:23], 0
    s_waitcnt lgkmcnt(3)
    v_mfma_f32_16x16x32_bf16 v[92:95], v[76:79], v[20:23], 0
    s_waitcnt lgkmcnt(0)
    v_lshlrev_b32 v116, 16, v112
    v_and_b32 v117, 0xffff0000, v112
    v_lshlrev_b32 v118, 16, v113
    v_and_b32 v119, 0xffff0000, v113
    v_cvt_pk_bf16_f32 v96, v80, v81
    v_cvt_pk_bf16_f32 v97, v82, v83
    v_cvt_pk_bf16_f32 v98, v84, v85
    v_cvt_pk_bf16_f32 v99, v86, v87
    v_cvt_pk_bf16_f32 v100, v88, v89
    v_cvt_pk_bf16_f32 v101, v90, v91
    v_cvt_pk_bf16_f32 v102, v92, v93
    v_cvt_pk_bf16_f32 v103, v94, v95
    s_nop 1
    v_mfma_f32_16x16x32_bf16 v[120:123], v[96:99], v[104:107], v[116:119]
    v_mfma_f32_16x16x32_bf16 v[120:123], v[100:103], v[108:111], v[120:123]
    s_nop 7
    v_pk_mul_f32 v[120:121], v[120:121], s[46:47]
    v_pk_mul_f32 v[122:123], v[122:123], s[46:47]
    ds_write_b128 v47, v[120:123]
    v_mov_b32 v5, 1
    s_mov_b64 exec, 1
    ds_add_u32 v17, v5 offset:4
    s_mov_b64 exec, -1
    s_branch L_nowb
.p2align 8
L_tab:
    .long 0x00003f80, 0x00000000, 0x0000ffff, 0x00000000, 0x3f800000, 0x00000000, 0xffff0000, 0x00000000
    .long 0x00000000, 0x00003f80, 0x00000000, 0x0000ffff, 0x00000000, 0x3f800000, 0x00000000, 0xffff0000
    .long 0x00000000, 0x00000000, 0x00000000, 0x00000000, 0x00000000, 0x00000000, 0x00000000, 0x00000000
    .long 0x00000000, 0x00000000, 0x00000000, 0x00000000, 0x00000000, 0x00000000, 0x00000000, 0x00000000
    .long 0x00000000, 0x00000000, 0x00000000, 0x00000000, 0x00000000, 0x00000000, 0x00000000, 0x00000000
    .long 0x00000000, 0x00000000, 0x00000000, 0x00000000, 0x00000000, 0x00000000, 0x00000000, 0x00000000
    .long 0x00000000, 0x00000000, 0x00000000, 0x00000000, 0x00000000, 0x00000000, 0x00000000, 0x00000000
    .long 0x00000000, 0x00000000, 0x00000000, 0x00000000, 0x00000000, 0x00000000, 0x00000000, 0x00000000
    .long 0x00000000, 0x00000000, 0x00000000, 0x00000000, 0x00000000, 0x00000000, 0x00000000, 0x00000000
    .long 0x00000000, 0x00000000, 0x00000000, 0x00000000, 0x00000000, 0x00000000, 0x00000000, 0x00000000
    .long 0x00003f80, 0x00000000, 0x0000ffff, 0x00000000, 0x3f800000, 0x00000000, 0xffff0000, 0x00000000
    .long 0x00000000, 0x00003f80, 0x00000000, 0x0000ffff, 0x00000000, 0x3f800000, 0x00000000, 0xffff0000
    .long 0x00000000, 0x00000000, 0x00000000, 0x00000000, 0x00000000, 0x00000000, 0x00000000, 0x00000000
    .long 0x00000000, 0x00000000, 0x00000000, 0x00000000, 0x00000000, 0x00000000, 0x00000000, 0x00000000
    .long 0x00000000, 0x00000000, 0x00000000, 0x00000000, 0x00000000, 0x00000000, 0x00000000, 0x00000000
    .long 0x00000000, 0x00000000, 0x00000000, 0x00000000, 0x00000000, 0x00000000, 0x00000000, 0x00000000
    .long 0x00000000, 0x00000000, 0x00000000, 0x00000000, 0x00000000, 0x00000000, 0x00000000, 0x00000000
    .long 0x00000000, 0x00000000, 0x00000000, 0x00000000, 0x00000000, 0x00000000, 0x00000000, 0x00000000
    .long 0x00000000, 0x00000000, 0x00000000, 0x00000000, 0x00000000, 0x00000000, 0x00000000, 0x00000000
    .long 0x00000000, 0x00000000, 0x00000000, 0x00000000, 0x00000000, 0x00000000, 0x00000000, 0x00000000
    .long 0x00003f80, 0x00000000, 0x0000ffff, 0x00000000, 0x3f800000, 0x00000000, 0xffff0000, 0x00000000
    .long 0x00000000, 0x00003f80, 0x00000000, 0x0000ffff, 0x00000000, 0x3f800000, 0x00000000, 0xffff0000
    .long 0x00000000, 0x00000000, 0x00000000, 0x00000000, 0x00000000, 0x00000000, 0x00000000, 0x00000000
    .long 0x00000000, 0x00000000, 0x00000000, 0x00000000, 0x00000000, 0x00000000, 0x00000000, 0x00000000
    .long 0x00000000, 0x00000000, 0x00000000, 0x00000000, 0x00000000, 0x00000000, 0x00000000, 0x00000000
    .long 0x00000000, 0x00000000, 0x00000000, 0x00000000, 0x00000000, 0x00000000, 0x00000000, 0x00000000
    .long 0x00000000, 0x00000000, 0x00000000, 0x00000000, 0x00000000, 0x00000000, 0x00000000, 0x00000000
    .long 0x00000000, 0x00000000, 0x00000000, 0x00000000, 0x00000000, 0x00000000, 0x00000000, 0x00000000
    .long 0x00000000, 0x00000000, 0x00000000, 0x00000000, 0x00000000, 0x00000000, 0x00000000, 0x00000000
    .long 0x00000000, 0x00000000, 0x00000000, 0x00000000, 0x00000000, 0x00000000, 0x00000000, 0x00000000
    .long 0x00003f80, 0x00000000, 0x0000ffff, 0x00000000, 0x3f800000, 0x00000000, 0xffff0000, 0x00000000
    .long 0x00000000, 0x00003f80, 0x00000000, 0x0000ffff, 0x00000000, 0x3f800000, 0x00000000, 0xffff0000
    .long 0x00000000, 0x00000000, 0x00000000, 0x00000000, 0x00000080, 0x00000008, 0x00000000, 0x00000000
    .long 0x00000140, 0x00000010, 0x00000000, 0x00000000, 0x000001c0, 0x00000018, 0x00000000, 0x00000000
    .long 0x00000200, 0x00000080, 0x00000000, 0x00000000, 0x00000280, 0x00000088, 0x00000000, 0x00000000
    .long 0x00000340, 0x00000090, 0x00000000, 0x00000000, 0x000003c0, 0x00000098, 0x00000000, 0x00000000
    .long 0x00000420, 0x00000140, 0x00000000, 0x00000000, 0x000004a0, 0x00000148, 0x00000000, 0x00000000
    .long 0x00000560, 0x00000150, 0x00000000, 0x00000000, 0x000005e0, 0x00000158, 0x00000000, 0x00000000
    .long 0x00000620, 0x000001c0, 0x00000000, 0x00000000, 0x000006a0, 0x000001c8, 0x00000000, 0x00000000
    .long 0x00000760, 0x000001d0, 0x00000000, 0x00000000, 0x000007e0, 0x000001d8, 0x00000000, 0x00000000
    .long 0x00000010, 0x00000020, 0x00000000, 0x00000000, 0x00000090, 0x00000028, 0x00000000, 0x00000000
    .long 0x00000150, 0x00000030, 0x00000000, 0x00000000, 0x000001d0, 0x00000038, 0x00000000, 0x00000000
    .long 0x00000210, 0x000000a0, 0x00000000, 0x00000000, 0x00000290, 0x000000a8, 0x00000000, 0x00000000
    .long 0x00000350, 0x000000b0, 0x00000000, 0x00000000, 0x000003d0, 0x000000b8, 0x00000000, 0x00000000
    .long 0x00000430, 0x00000160, 0x00000000, 0x00000000, 0x000004b0, 0x00000168, 0x00000000, 0x00000000
    .long 0x00000570, 0x00000170, 0x00000000, 0x00000000, 0x000005f0, 0x00000178, 0x00000000, 0x00000000
    .long 0x00000630, 0x000001e0, 0x00000000, 0x00000000, 0x000006b0, 0x000001e8, 0x00000000, 0x00000000
    .long 0x00000770, 0x000001f0, 0x00000000, 0x00000000, 0x000007f0, 0x000001f8, 0x00000000, 0x00000000
    .long 0x00000020, 0x00000040, 0x00000000, 0x00000000, 0x000000a0, 0x00000048, 0x00000000, 0x00000000
    .long 0x00000160, 0x00000050, 0x00000000, 0x00000000, 0x000001e0, 0x00000058, 0x00000000, 0x00000000
    .long 0x00000220, 0x000000c0, 0x00000000, 0x00000000, 0x000002a0, 0x000000c8, 0x00000000, 0x00000000
    .long 0x00000360, 0x000000d0, 0x00000000, 0x00000000, 0x000003e0, 0x000000d8, 0x00000000, 0x00000000
    .long 0x00000400, 0x00000100, 0x00000000, 0x00000000, 0x00000480, 0x00000108, 0x00000000, 0x00000000
    .long 0x00000540, 0x00000110, 0x00000000, 0x00000000, 0x000005c0, 0x00000118, 0x00000000, 0x00000000
    .long 0x00000600, 0x00000180, 0x00000000, 0x00000000, 0x00000680, 0x00000188, 0x00000000, 0x00000000
    .long 0x00000740, 0x00000190, 0x00000000, 0x00000000, 0x000007c0, 0x00000198, 0x00000000, 0x00000000
    .long 0x00000030, 0x00000060, 0x00000000, 0x00000000, 0x000000b0, 0x00000068, 0x00000000, 0x00000000
    .long 0x00000170, 0x00000070, 0x00000000, 0x00000000, 0x000001f0, 0x00000078, 0x00000000, 0x00000000
    .long 0x00000230, 0x000000e0, 0x00000000, 0x00000000, 0x000002b0, 0x000000e8, 0x00000000, 0x00000000
    .long 0x00000370, 0x000000f0, 0x00000000, 0x00000000, 0x000003f0, 0x000000f8, 0x00000000, 0x00000000
    .long 0x00000410, 0x00000120, 0x00000000, 0x00000000, 0x00000490, 0x00000128, 0x00000000, 0x00000000
    .long 0x00000550, 0x00000130, 0x00000000, 0x00000000, 0x000005d0, 0x00000138, 0x00000000, 0x00000000
    .long 0x00000610, 0x000001a0, 0x00000000, 0x00000000, 0x00000690, 0x000001a8, 0x00000000, 0x00000000
    .long 0x00000750, 0x000001b0, 0x00000000, 0x00000000, 0x000007d0, 0x000001b8, 0x00000000, 0x00000000

.section .rodata,"a"
.p2align 6
.amdhsa_kernel standalone__sequential_behavior_din__recsys_kernel
  .amdhsa_next_free_vgpr 128
  .amdhsa_next_free_sgpr 72
  .amdhsa_accum_offset 128
  .amdhsa_group_segment_fixed_size 0
  .amdhsa_kernarg_size 80
  .amdhsa_user_sgpr_count 2
  .amdhsa_user_sgpr_kernarg_segment_ptr 1
  .amdhsa_system_sgpr_workgroup_id_x 1
.end_amdhsa_kernel
```
